```python
import torch

def _softmax(x, axis=-1):
    return torch.softmax(x, dim=axis)
def _gelu(x):
    return torch.nn.functional.gelu(x, approximate="tanh")
def _silu(x):
    return torch.nn.functional.silu(x)
def _sigmoid(x):
    return torch.sigmoid(x)
def _layernorm(x, axis=-1, eps=1e-5):
    m = x.mean(dim=axis, keepdim=True)
    v = x.var(dim=axis, keepdim=True, unbiased=False)
    return (x - m) / torch.sqrt(v + eps)
def _scatter_add(tgt, idx, src, axis=0):
    return tgt.clone().index_add_(axis, idx, src)
def _segment_sum(src, seg, n):
    out = torch.zeros((n,) + src.shape[1:], dtype=src.dtype)
    return out.index_add_(0, seg, src)
def _pad(x, pw):
    flat = tuple(v for pair in reversed(pw) for v in pair)
    return torch.nn.functional.pad(x, flat)

kernel_name = 'parallel_sum__sliding_block_cached__swiglu_ffn__decode'

def setup_inputs():

    _w = (lambda a: (lambda t: t.to(torch.bfloat16) if t.is_floating_point() else t)(torch.as_tensor(a)))
    def _A_setup():
        B, Sq, D = 1, 1, 512
        Hq, Hkv, Sk, Dh = 32, 8, 32768, 128
        assert Hq % Hkv == 0, (Hq, Hkv)
        return {
            "x": _w((lambda *s: torch.randn(*s, dtype=torch.bfloat16) * 0.05)(B, Sq, D)),
            "k_cache": _w((lambda *s: torch.randn(*s, dtype=torch.bfloat16) * 3.2)(B, Hkv, Sk, Dh)),
            "v_cache": _w((lambda *s: torch.randn(*s, dtype=torch.bfloat16) * 1.6)(B, Hkv, Sk, Dh)),
            "wq": _w((lambda *s: torch.randn(*s, dtype=torch.bfloat16) * 3.2)(D, Hq * Dh) * (D ** -0.5)),
            "wo": _w((lambda *s: torch.randn(*s, dtype=torch.bfloat16) * 1.6)(Hq * Dh, D) * ((Hq * Dh) ** -0.5)),
        }
    _A_in = _A_setup()

    def _B_setup():
        B, S, D, F = 1, 1, 512, 1792
        return {
            "x": _w((lambda *s: torch.randn(*s, dtype=torch.bfloat16) * 0.05)(B, S, D)),
            "w_gate": _w((lambda *s: torch.randn(*s, dtype=torch.bfloat16) * 0.05)(D, F)),
            "w_up": _w((lambda *s: torch.randn(*s, dtype=torch.bfloat16) * 0.05)(D, F)),
            "w_down": _w((lambda *s: torch.randn(*s, dtype=torch.bfloat16) * 0.05)(F, D)),
        }
    _B_in = _B_setup()

    return {
        "A_x": _A_in["x"],
        "A_k_cache": _A_in["k_cache"],
        "A_v_cache": _A_in["v_cache"],
        "A_wq": _A_in["wq"],
        "A_wo": _A_in["wo"],
        "B_x": _B_in["x"],
        "B_w_gate": _B_in["w_gate"],
        "B_w_up": _B_in["w_up"],
        "B_w_down": _B_in["w_down"],
    }

def reference(A_x, A_k_cache, A_v_cache, A_wq, A_wo, B_x, B_w_gate, B_w_up, B_w_down):
    def _A_ref(x, k_cache, v_cache, wq, wo):
        B, Sq, D = x.shape
        Hq, Dh = 32, 128
        Hkv, Sk = k_cache.shape[1], k_cache.shape[2]
        W = min(4096, max(256, Sk // 4))
        rep = Hq // Hkv
        q = (lambda x, *d: x.permute(*d))((x @ wq).reshape(B, Sq, Hq, Dh), 0, 2, 1, 3)
        k = (lambda x, n, axis: torch.repeat_interleave(x, n, dim=axis))(k_cache[:, :, Sk - W:, :], rep, axis=1)
        v = (lambda x, n, axis: torch.repeat_interleave(x, n, dim=axis))(v_cache[:, :, Sk - W:, :], rep, axis=1)
        scores = torch.einsum("bhqd,bhkd->bhqk", q, k) * (Dh ** -0.5)
        p = _softmax(scores, axis=-1)
        o = torch.einsum("bhqk,bhkd->bhqd", p, v)
        return (lambda x, *d: x.permute(*d))(o, 0, 2, 1, 3).reshape(B, Sq, Hq * Dh) @ wo

    def _B_ref(x, w_gate, w_up, w_down):
        g = _silu(x @ w_gate)
        u = x @ w_up
        return (g * u) @ w_down

    x = A_x
    xn = _layernorm(x, axis=-1)
    return x + _A_ref(xn, A_k_cache, A_v_cache, A_wq, A_wo) + _B_ref(xn, B_w_gate, B_w_up, B_w_down)
```

```asm
; @launch grid=(256,1,1) block=(640,1,1) lds=126976
.amdgcn_target "amdgcn-amd-amdhsa--gfx950"
.text
.globl parallel_sum__sliding_block_cached__swiglu_ffn__decode_kernel
.p2align 8
.type parallel_sum__sliding_block_cached__swiglu_ffn__decode_kernel,@function
parallel_sum__sliding_block_cached__swiglu_ffn__decode_kernel:
    s_cmp_ge_u32 s2, 256
    s_cbranch_scc1 L_end
    s_load_dwordx16 s[4:19], s[0:1], 0
    s_load_dwordx8 s[20:27], s[0:1], 64
    v_and_b32 v1, 63, v0
    v_lshrrev_b32 v3, 6, v0
    v_lshlrev_b32 v2, 4, v1
    v_readfirstlane_b32 s3, v3
    s_and_b32 s28, s2, 7
    s_lshr_b32 s29, s2, 3
    s_lshr_b32 s100, s29, 3
    s_lshl_b32 s100, s100, 3
    s_add_u32 s100, s100, s28
    v_lshrrev_b32 v7, 4, v1
    v_and_b32 v8, 15, v1
    v_mov_b32 v9, 0
    v_mov_b32 v11, 1
    s_cmp_eq_u32 s3, 8
    s_cbranch_scc1 L_loader
    s_cmp_eq_u32 s3, 9
    s_cbranch_scc1 L_aux
    s_lshr_b32 s36, s29, 3
    s_and_b32 s39, s29, 7
    s_and_b32 s34, s3, 3
    s_lshr_b32 s35, s3, 2
    s_mov_b32 s96, 0x07060500
    s_mov_b32 s97, 0x07060501
    s_mov_b32 s98, 0x07060502
    s_mov_b32 s99, 0x07060503
    s_mov_b32 s95, 0x0c0c0400
    s_mov_b32 s94, 0x05040100
    s_cmp_lt_u32 s3, 2
    s_cbranch_scc1 L_w01
    s_cmp_eq_u32 s3, 2
    s_cbranch_scc0 L_noinit
    v_lshlrev_b32 v3, 2, v1
    v_add_u32 v3, 3456, v3
    v_mov_b32 v4, 0
    v_mov_b32 v5, 0xff800000
    v_subrev_u32 v6, 4, v1
    v_cmp_gt_u32 vcc, 4, v6
    s_nop 1
    v_cndmask_b32 v4, v4, v5, vcc
    ds_write_b32 v3, v4
L_noinit:
    s_waitcnt lgkmcnt(0)
    s_load_dword s30, s[26:27], 0
    s_barrier
    s_waitcnt lgkmcnt(0)
    s_mul_i32 s30, s30, 1664525
    s_add_u32 s30, s30, 1013904223
    v_mov_b32 v10, s30
    s_branch L_hoist
L_w01:
    s_setprio 2
    s_waitcnt lgkmcnt(0)
    global_load_dwordx4 v[12:15], v2, s[4:5]
    s_load_dword s30, s[26:27], 0
    s_barrier
    s_lshl_b32 s31, s3, 2
    v_lshrrev_b32 v3, 2, v1
    v_bfe_u32 v4, v3, 1, 2
    v_lshlrev_b32 v4, 1, v4
    v_bfe_u32 v6, v1, 1, 1
    v_add_u32 v6, s31, v6
    v_xor_b32 v6, v6, v4
    v_lshlrev_b32 v6, 4, v6
    v_lshl_add_u32 v6, v3, 7, v6
    v_and_b32 v5, 1, v1
    v_lshl_add_u32 v91, v5, 3, v6
    v_xor_b32 v92, 32, v91
    s_lshl_b32 s31, s36, 8
    v_lshl_add_u32 v93, v7, 3, s31
    s_lshl_b32 s31, s28, 13
    s_lshl_b32 s32, s36, 11
    s_add_u32 s31, s31, s32
    s_lshl_b32 s32, s39, 8
    s_add_u32 s31, s31, s32
    s_lshl_b32 s32, s3, 7
    s_add_u32 s31, s31, s32
    s_add_u32 s31, s31, 4096
    v_lshlrev_b32 v3, 5, v7
    v_lshl_add_u32 v3, v8, 4, v3
    v_add_u32 v94, s31, v3
    s_waitcnt vmcnt(0) lgkmcnt(0)
    s_mul_i32 s30, s30, 1664525
    s_add_u32 s30, s30, 1013904223
    v_mov_b32 v10, s30
    v_lshlrev_b32 v16, 16, v12
    v_and_b32 v17, 0xffff0000, v12
    v_lshlrev_b32 v18, 16, v13
    v_and_b32 v19, 0xffff0000, v13
    v_lshlrev_b32 v20, 16, v14
    v_and_b32 v21, 0xffff0000, v14
    v_lshlrev_b32 v22, 16, v15
    v_and_b32 v23, 0xffff0000, v15
    v_add_f32 v24, v16, v17
    v_add_f32 v25, v18, v19
    v_add_f32 v3, v20, v21
    v_add_f32 v4, v22, v23
    v_add_f32 v24, v24, v25
    v_add_f32 v3, v3, v4
    v_add_f32 v24, v24, v3
    s_nop 1
    v_add_f32_dpp v24, v24, v24 row_ror:8 row_mask:0xf bank_mask:0xf
    s_nop 1
    v_add_f32_dpp v24, v24, v24 row_ror:4 row_mask:0xf bank_mask:0xf
    s_nop 1
    v_add_f32_dpp v24, v24, v24 row_ror:2 row_mask:0xf bank_mask:0xf
    s_nop 1
    v_add_f32_dpp v24, v24, v24 row_ror:1 row_mask:0xf bank_mask:0xf
    s_nop 1
    v_add_f32_dpp v24, v24, v24 row_bcast:15 row_mask:0xa bank_mask:0xf
    s_nop 1
    v_add_f32_dpp v24, v24, v24 row_bcast:31 row_mask:0xc bank_mask:0xf
    s_nop 0
    v_readlane_b32 s31, v24, 63
    s_nop 1
    v_mov_b32 v3, s31
    v_mul_f32 v3, 0x3b000000, v3
    v_sub_f32 v4, v16, v3
    v_mul_f32 v25, v4, v4
    v_sub_f32 v4, v17, v3
    v_fmac_f32 v25, v4, v4
    v_sub_f32 v4, v18, v3
    v_fmac_f32 v25, v4, v4
    v_sub_f32 v4, v19, v3
    v_fmac_f32 v25, v4, v4
    v_sub_f32 v4, v20, v3
    v_fmac_f32 v25, v4, v4
    v_sub_f32 v4, v21, v3
    v_fmac_f32 v25, v4, v4
    v_sub_f32 v4, v22, v3
    v_fmac_f32 v25, v4, v4
    v_sub_f32 v4, v23, v3
    v_fmac_f32 v25, v4, v4
    s_nop 1
    v_add_f32_dpp v25, v25, v25 row_ror:8 row_mask:0xf bank_mask:0xf
    s_nop 1
    v_add_f32_dpp v25, v25, v25 row_ror:4 row_mask:0xf bank_mask:0xf
    s_nop 1
    v_add_f32_dpp v25, v25, v25 row_ror:2 row_mask:0xf bank_mask:0xf
    s_nop 1
    v_add_f32_dpp v25, v25, v25 row_ror:1 row_mask:0xf bank_mask:0xf
    s_nop 1
    v_add_f32_dpp v25, v25, v25 row_bcast:15 row_mask:0xa bank_mask:0xf
    s_nop 1
    v_add_f32_dpp v25, v25, v25 row_bcast:31 row_mask:0xc bank_mask:0xf
    s_nop 0
    v_readlane_b32 s32, v25, 63
    v_cvt_pk_bf16_f32 v3, v3, v3
    v_lshlrev_b32 v3, 16, v3
    v_mov_b32 v4, s32
    v_mul_f32 v4, 0x3b000000, v4
    v_cvt_pk_bf16_f32 v4, v4, v4
    v_lshlrev_b32 v4, 16, v4
    v_add_f32 v4, 0x3727c5ac, v4
    v_cvt_pk_bf16_f32 v4, v4, v4
    v_lshlrev_b32 v4, 16, v4
    v_sqrt_f32 v4, v4
    v_sub_f32 v16, v16, v3
    v_sub_f32 v17, v17, v3
    v_cvt_pk_bf16_f32 v6, v16, v17
    v_lshlrev_b32 v16, 16, v6
    v_and_b32 v17, 0xffff0000, v6
    v_sub_f32 v18, v18, v3
    v_sub_f32 v19, v19, v3
    v_cvt_pk_bf16_f32 v6, v18, v19
    v_lshlrev_b32 v18, 16, v6
    v_and_b32 v19, 0xffff0000, v6
    v_sub_f32 v20, v20, v3
    v_sub_f32 v21, v21, v3
    v_cvt_pk_bf16_f32 v6, v20, v21
    v_lshlrev_b32 v20, 16, v6
    v_and_b32 v21, 0xffff0000, v6
    v_sub_f32 v22, v22, v3
    v_sub_f32 v23, v23, v3
    v_cvt_pk_bf16_f32 v6, v22, v23
    v_lshlrev_b32 v22, 16, v6
    v_and_b32 v23, 0xffff0000, v6
    v_cvt_pk_bf16_f32 v4, v4, v4
    v_lshlrev_b32 v4, 16, v4
    v_rcp_f32 v5, v4
    s_nop 0
    v_mul_f32 v24, v16, v5
    v_fma_f32 v25, -v24, v4, v16
    v_fma_f32 v16, v25, v5, v24
    v_mul_f32 v24, v17, v5
    v_fma_f32 v25, -v24, v4, v17
    v_fma_f32 v17, v25, v5, v24
    v_mul_f32 v24, v18, v5
    v_fma_f32 v25, -v24, v4, v18
    v_fma_f32 v18, v25, v5, v24
    v_mul_f32 v24, v19, v5
    v_fma_f32 v25, -v24, v4, v19
    v_fma_f32 v19, v25, v5, v24
    v_mul_f32 v24, v20, v5
    v_fma_f32 v25, -v24, v4, v20
    v_fma_f32 v20, v25, v5, v24
    v_mul_f32 v24, v21, v5
    v_fma_f32 v25, -v24, v4, v21
    v_fma_f32 v21, v25, v5, v24
    v_mul_f32 v24, v22, v5
    v_fma_f32 v25, -v24, v4, v22
    v_fma_f32 v22, v25, v5, v24
    v_mul_f32 v24, v23, v5
    v_fma_f32 v25, -v24, v4, v23
    v_fma_f32 v23, v25, v5, v24
    v_cvt_pk_bf16_f32 v12, v16, v17
    v_cvt_pk_bf16_f32 v13, v18, v19
    v_cvt_pk_bf16_f32 v14, v20, v21
    v_cvt_pk_bf16_f32 v15, v22, v23
    ds_write_b128 v2, v[12:15] offset:0
    s_waitcnt lgkmcnt(0)
    ds_read2_b64 v[28:31], v93 offset0:0 offset1:4
    ds_read2_b64 v[32:35], v93 offset0:8 offset1:12
    ds_read2_b64 v[36:39], v93 offset0:16 offset1:20
    ds_read2_b64 v[40:43], v93 offset0:24 offset1:28
    s_mov_b32 s38, 0
L_spin1:
    ds_read_b128 v[72:75], v9 offset:3456
    s_waitcnt lgkmcnt(0)
    v_cmp_gt_u32 vcc, 1, v72
    s_add_u32 s38, s38, 1
    s_cmp_gt_u32 s38, 200000
    s_cbranch_scc1 L_spin1_x
    s_cbranch_vccnz L_spin1
L_spin1_x:
    ds_read_b64_tr_b16 v[12:13], v91 offset:4096
    ds_read_b64_tr_b16 v[14:15], v91 offset:6144
    ds_read_b64_tr_b16 v[16:17], v91 offset:8192
    ds_read_b64_tr_b16 v[18:19], v91 offset:10240
    ds_read_b64_tr_b16 v[20:21], v91 offset:12288
    ds_read_b64_tr_b16 v[22:23], v91 offset:14336
    ds_read_b64_tr_b16 v[24:25], v91 offset:16384
    ds_read_b64_tr_b16 v[26:27], v91 offset:18432
    ds_read_b64_tr_b16 v[44:45], v92 offset:4096
    ds_read_b64_tr_b16 v[46:47], v92 offset:6144
    ds_read_b64_tr_b16 v[48:49], v92 offset:8192
    ds_read_b64_tr_b16 v[50:51], v92 offset:10240
    ds_read_b64_tr_b16 v[52:53], v92 offset:12288
    ds_read_b64_tr_b16 v[54:55], v92 offset:14336
    s_waitcnt lgkmcnt(12)
    ds_read_b64_tr_b16 v[56:57], v92 offset:16384
    ds_read_b64_tr_b16 v[58:59], v92 offset:18432
    s_waitcnt lgkmcnt(14)
    v_mfma_f32_16x16x32_bf16 v[60:63], v[12:15], v[28:31], 0
    s_waitcnt lgkmcnt(12)
    v_mfma_f32_16x16x32_bf16 v[60:63], v[16:19], v[32:35], v[60:63]
    s_waitcnt lgkmcnt(10)
    v_mfma_f32_16x16x32_bf16 v[60:63], v[20:23], v[36:39], v[60:63]
    s_waitcnt lgkmcnt(8)
    v_mfma_f32_16x16x32_bf16 v[60:63], v[24:27], v[40:43], v[60:63]
    s_waitcnt lgkmcnt(6)
    v_mfma_f32_16x16x32_bf16 v[64:67], v[44:47], v[28:31], 0
    s_waitcnt lgkmcnt(4)
    v_mfma_f32_16x16x32_bf16 v[64:67], v[48:51], v[32:35], v[64:67]
    s_waitcnt lgkmcnt(2)
    v_mfma_f32_16x16x32_bf16 v[64:67], v[52:55], v[36:39], v[64:67]
    s_waitcnt lgkmcnt(0)
    v_mfma_f32_16x16x32_bf16 v[64:67], v[56:59], v[40:43], v[64:67]
    v_cmp_eq_u32 vcc, 1, v8
    v_cmp_gt_u32 s[32:33], 2, v8
    s_nop 6
    v_cndmask_b32 v60, v60, v64, vcc
    v_cndmask_b32 v61, v61, v65, vcc
    v_cndmask_b32 v62, v62, v66, vcc
    v_cndmask_b32 v63, v63, v67, vcc
    v_perm_b32 v68, v60, v10, s96
    v_perm_b32 v69, v61, v10, s97
    v_perm_b32 v70, v62, v10, s98
    v_perm_b32 v71, v63, v10, s99
    s_mov_b64 exec, s[32:33]
    global_store_dwordx4 v94, v[68:71], s[26:27] sc1
    s_mov_b64 exec, -1
    s_cmp_eq_u32 s3, 0
    s_cbranch_scc0 L_noinfo
    s_getreg_b32 s31, hwreg(HW_REG_XCC_ID, 0, 4)
    s_lshl_b32 s31, s31, 8
    v_mov_b32 v3, s31
    v_perm_b32 v68, v3, v10, s96
    v_perm_b32 v69, v3, v10, s97
    v_perm_b32 v70, v3, v10, s98
    v_perm_b32 v71, v3, v10, s99
    s_lshl_b32 s31, s28, 12
    s_lshl_b32 s32, s29, 7
    s_add_u32 s31, s31, s32
    s_add_u32 s31, s31, 917504
    v_mov_b32 v3, s31
    s_mov_b64 exec, 1
    global_store_dwordx4 v3, v[68:71], s[26:27] sc1
    s_mov_b64 exec, -1
L_noinfo:
    s_setprio 0
L_hoist:
    s_lshl_b32 s31, s34, 1
    v_lshrrev_b32 v3, 2, v1
    v_bfe_u32 v4, v3, 1, 2
    v_lshlrev_b32 v4, 1, v4
    v_bfe_u32 v6, v1, 1, 1
    v_add_u32 v6, s31, v6
    v_xor_b32 v6, v6, v4
    v_lshlrev_b32 v6, 4, v6
    v_lshl_add_u32 v6, v3, 7, v6
    v_and_b32 v5, 1, v1
    v_lshl_add_u32 v95, v5, 3, v6
    v_add_u32 v95, 20480, v95
    s_and_b32 s31, s29, 7
    s_lshl_b32 s31, s31, 7
    v_lshl_add_u32 v96, v7, 3, s31
    s_lshl_b32 s31, s100, 12
    s_and_b32 s32, s29, 7
    s_lshl_b32 s32, s32, 9
    s_add_u32 s31, s31, s32
    s_lshl_b32 s32, s34, 6
    s_add_u32 s31, s31, s32
    s_add_u32 s31, s31, 73728
    v_lshlrev_b32 v3, 4, v7
    v_lshl_add_u32 v3, v8, 8, v3
    v_add_u32 v116, s31, v3
    s_lshl_b32 s31, s28, 13
    s_lshl_b32 s32, s34, 9
    s_add_u32 s31, s31, s32
    s_add_u32 s31, s31, 4096
    v_and_b32 v3, 31, v1
    v_lshrrev_b32 v4, 5, v1
    v_lshlrev_b32 v4, 12, v4
    v_lshl_add_u32 v4, v3, 4, v4
    v_add_u32 v97, s31, v4
    v_and_b32 v4, 24, v3
    v_and_b32 v5, 1, v3
    v_lshl_add_u32 v4, v5, 2, v4
    v_bfe_u32 v5, v3, 1, 2
    v_add_u32 v4, v4, v5
    s_mul_i32 s31, s34, 320
    s_add_u32 s31, s31, 1024
    v_lshl_add_u32 v98, v4, 3, s31
    v_xor_b32 v3, v8, v7
    s_lshl_b32 s31, s3, 12
    s_add_u32 s31, s31, 36864
    v_lshl_add_u32 v4, v8, 8, s31
    v_xor_b32 v5, 0, v3
    v_lshl_add_u32 v99, v5, 4, v4
    v_xor_b32 v5, 4, v3
    v_lshl_add_u32 v100, v5, 4, v4
    v_xor_b32 v5, 8, v3
    v_lshl_add_u32 v101, v5, 4, v4
    v_xor_b32 v5, 12, v3
    v_lshl_add_u32 v102, v5, 4, v4
    v_and_b32 v3, 3, v8
    v_mul_u32_u24 v4, 320, v3
    v_lshl_add_u32 v4, v7, 4, v4
    v_add_u32 v103, 1024, v4
    v_lshlrev_b32 v104, 2, v3
    v_lshlrev_b32 v4, 4, v3
    v_lshl_add_u32 v106, v7, 6, v4
    s_lshr_b32 s31, s3, 1
    s_lshl_b32 s31, s31, 8
    s_and_b32 s32, s3, 1
    s_lshl_b32 s32, s32, 3
    s_add_u32 s31, s31, s32
    s_add_u32 s31, s31, 2304
    v_add_u32 v105, s31, v106
    v_lshlrev_b32 v108, 5, v3
    s_lshl_b32 s31, s3, 2
    s_add_u32 s31, s31, 3328
    v_add_u32 v107, s31, v108
    v_lshrrev_b32 v3, 2, v1
    v_and_b32 v4, 7, v3
    v_lshlrev_b32 v4, 1, v4
    v_bfe_u32 v6, v1, 1, 1
    s_lshl_b32 s31, s3, 1
    v_add_u32 v6, s31, v6
    v_xor_b32 v6, v6, v4
    v_and_b32 v5, 1, v1
    v_lshlrev_b32 v5, 3, v5
    v_lshl_add_u32 v5, v3, 8, v5
    v_lshl_add_u32 v5, v6, 4, v5
    v_add_u32 v109, 69632, v5
    s_mul_i32 s31, s28, 73728
    s_add_u32 s33, s31, 196608
    s_mul_i32 s31, s29, 2304
    s_add_u32 s31, s31, s33
    v_lshl_add_u32 v111, v1, 4, s31
    s_lshl_b32 s32, s3, 6
    s_add_u32 s31, s31, s32
    v_lshlrev_b32 v3, 4, v7
    v_lshl_add_u32 v3, v8, 9, v3
    v_add_u32 v110, s31, v3
    v_lshrrev_b32 v3, 2, v1
    v_mul_u32_u24 v4, 2304, v3
    s_lshl_b32 s31, s36, 4
    s_add_u32 s31, s31, s33
    s_add_u32 s31, s31, 2048
    v_add_u32 v114, s31, v4
    v_add_u32 v115, 36864, v114
    s_bfe_u32 s32, s29, 0x10002
    s_lshl_b32 s32, s32, 2
    s_add_u32 s32, s32, s34
    s_lshl_b32 s32, s32, 6
    s_lshl_b32 s31, s36, 9
    s_add_u32 s31, s31, s32
    s_add_u32 s31, s31, s33
    v_and_b32 v5, 3, v1
    v_lshl_add_u32 v4, v5, 4, v4
    v_add_u32 v112, s31, v4
    v_add_u32 v113, 36864, v112
    s_lshl_b32 s31, s2, 9
    s_lshl_b32 s32, s3, 6
    s_add_u32 s31, s31, s32
    s_add_u32 s31, s31, 786432
    v_lshl_add_u32 v121, v7, 4, s31
    v_add_u32 v118, 32768, v109
    v_lshlrev_b32 v3, 4, v7
    v_add_u32 v119, 3520, v3
    s_lshr_b32 s31, s34, 1
    s_lshl_b32 s31, s31, 6
    s_and_b32 s32, s34, 1
    s_lshl_b32 s32, s32, 3
    s_add_u32 s31, s31, s32
    s_add_u32 s31, s31, 3520
    v_and_b32 v3, 3, v1
    v_lshl_add_u32 v120, v3, 4, s31
    v_and_b32 v3, 1, v7
    v_lshlrev_b32 v3, 2, v3
    v_lshrrev_b32 v4, 1, v7
    v_lshl_add_u32 v3, v4, 1, v3
    v_add_u32 v120, v120, v3
    s_cmp_ge_u32 s3, 4
    s_cbranch_scc0 L_noh1
    s_mov_b32 s38, 0
    s_branch L_spin2_e
L_spin2:
    s_sleep 1
L_spin2_e:
    ds_read_b128 v[72:75], v9 offset:3456
    s_waitcnt lgkmcnt(0)
    v_cmp_gt_u32 vcc, 2, v72
    s_add_u32 s38, s38, 1
    s_cmp_gt_u32 s38, 200000
    s_cbranch_scc1 L_spin2_x
    s_cbranch_vccnz L_spin2
L_spin2_x:
    s_cmp_eq_u32 s3, 4
    s_cbranch_scc0 L_h1_plain
    s_lshl_b32 s31, s28, 12
    s_add_u32 s31, s31, 917504
    v_and_b32 v89, 31, v1
    v_lshl_add_u32 v89, v89, 7, s31
    s_mov_b32 s37, 0
    global_load_dwordx4 v[44:47], v97, s[26:27] sc1
    global_load_dwordx4 v[48:51], v97, s[26:27] offset:2048 sc1
    global_load_dwordx4 v[52:55], v89, s[26:27] sc1
L_poll3:
    s_waitcnt vmcnt(0)
    v_perm_b32 v3, v45, v44, s95
    v_perm_b32 v4, v47, v46, s95
    v_perm_b32 v3, v4, v3, s94
    v_xor_b32 v5, v3, v10
    v_perm_b32 v3, v49, v48, s95
    v_perm_b32 v4, v51, v50, s95
    v_perm_b32 v3, v4, v3, s94
    v_xor_b32 v3, v3, v10
    v_or_b32 v5, v5, v3
    v_perm_b32 v3, v53, v52, s95
    v_perm_b32 v4, v55, v54, s95
    v_perm_b32 v3, v4, v3, s94
    v_xor_b32 v3, v3, v10
    v_or_b32 v5, v5, v3
    v_cmp_ne_u32 vcc, 0, v5
    s_cbranch_vccz L_poll3_x
    s_add_u32 s37, s37, 1
    s_cmp_gt_u32 s37, 200000
    s_cbranch_scc1 L_poll3_x
    s_mov_b64 exec, vcc
    global_load_dwordx4 v[44:47], v97, s[26:27] sc1
    global_load_dwordx4 v[48:51], v97, s[26:27] offset:2048 sc1
    global_load_dwordx4 v[52:55], v89, s[26:27] sc1
    s_branch L_poll3
L_poll3_x:
    s_mov_b64 exec, -1
    s_getreg_b32 s31, hwreg(HW_REG_XCC_ID, 0, 4)
    s_lshl_b32 s31, s31, 8
    v_and_b32 v52, 0xffffff00, v52
    v_cmp_ne_u32 vcc, s31, v52
    s_cmp_eq_u64 vcc, 0
    s_cselect_b32 s31, 1, 0
    v_mov_b32 v90, s31
    s_mov_b64 exec, 1
    ds_write_b32 v9, v90 offset:3488
    s_mov_b64 exec, -1
    s_branch L_h1_done
L_h1_plain:
    s_mov_b32 s37, 0
    global_load_dwordx4 v[44:47], v97, s[26:27] sc1
    global_load_dwordx4 v[48:51], v97, s[26:27] offset:2048 sc1
L_poll4:
    s_waitcnt vmcnt(0)
    v_perm_b32 v3, v45, v44, s95
    v_perm_b32 v4, v47, v46, s95
    v_perm_b32 v3, v4, v3, s94
    v_xor_b32 v5, v3, v10
    v_perm_b32 v3, v49, v48, s95
    v_perm_b32 v4, v51, v50, s95
    v_perm_b32 v3, v4, v3, s94
    v_xor_b32 v3, v3, v10
    v_or_b32 v5, v5, v3
    v_cmp_ne_u32 vcc, 0, v5
    s_cbranch_vccz L_poll4_x
    s_add_u32 s37, s37, 1
    s_cmp_gt_u32 s37, 200000
    s_cbranch_scc1 L_poll4_x
    s_mov_b64 exec, vcc
    global_load_dwordx4 v[44:47], v97, s[26:27] sc1
    global_load_dwordx4 v[48:51], v97, s[26:27] offset:2048 sc1
    s_branch L_poll4
L_poll4_x:
    s_mov_b64 exec, -1
L_h1_done:
    v_and_b32 v44, 0xffffff00, v44
    v_and_b32 v45, 0xffffff00, v45
    v_and_b32 v46, 0xffffff00, v46
    v_and_b32 v47, 0xffffff00, v47
    v_and_b32 v48, 0xffffff00, v48
    v_and_b32 v49, 0xffffff00, v49
    v_and_b32 v50, 0xffffff00, v50
    v_and_b32 v51, 0xffffff00, v51
    v_add_f32 v44, v44, v48
    v_add_f32 v45, v45, v49
    v_add_f32 v46, v46, v50
    v_add_f32 v47, v47, v51
    v_mov_b32 v48, v44
    v_mov_b32 v49, v45
    v_mov_b32 v50, v46
    v_mov_b32 v51, v47
    s_nop 0
    v_permlane32_swap_b32 v44, v48
    v_permlane32_swap_b32 v45, v49
    v_permlane32_swap_b32 v46, v50
    v_permlane32_swap_b32 v47, v51
    v_add_f32 v44, v44, v48
    v_add_f32 v45, v45, v49
    v_add_f32 v46, v46, v50
    v_add_f32 v47, v47, v51
    v_cvt_pk_bf16_f32 v52, v44, v45
    v_cvt_pk_bf16_f32 v53, v46, v47
    s_mov_b32 exec_hi, 0
    ds_write_b64 v98, v[52:53]
    s_mov_b64 exec, 1
    ds_add_u32 v9, v11 offset:3460
    s_mov_b64 exec, -1
L_noh1:
    s_mov_b32 s38, 0
    s_branch L_spin5_e
L_spin5:
    s_sleep 1
L_spin5_e:
    ds_read_b128 v[72:75], v9 offset:3456
    s_waitcnt lgkmcnt(0)
    v_cmp_gt_u32 vcc, 3, v72
    v_cmp_gt_u32 s[32:33], 4, v73
    s_or_b64 vcc, vcc, s[32:33]
    s_add_u32 s38, s38, 1
    s_cmp_gt_u32 s38, 200000
    s_cbranch_scc1 L_spin5_x
    s_cbranch_vccnz L_spin5
L_spin5_x:
    ds_read_b128 v[28:31], v103 offset:0
    ds_read_b128 v[32:35], v103 offset:64
    ds_read_b128 v[36:39], v103 offset:128
    ds_read_b128 v[40:43], v103 offset:192
    ds_read_b128 v[12:15], v99
    ds_read_b128 v[16:19], v100
    ds_read_b128 v[20:23], v101
    ds_read_b128 v[24:27], v102
    s_waitcnt lgkmcnt(3)
    v_mfma_f32_16x16x32_bf16 v[60:63], v[12:15], v[28:31], 0
    s_waitcnt lgkmcnt(2)
    v_mfma_f32_16x16x32_bf16 v[60:63], v[16:19], v[32:35], v[60:63]
    s_waitcnt lgkmcnt(1)
    v_mfma_f32_16x16x32_bf16 v[60:63], v[20:23], v[36:39], v[60:63]
    s_waitcnt lgkmcnt(0)
    v_mfma_f32_16x16x32_bf16 v[60:63], v[24:27], v[40:43], v[60:63]
    ds_read_b32 v90, v9 offset:3488
    s_mov_b32 s31, 0x3db504f3
    s_nop 6
    v_cvt_pk_bf16_f32 v84, v60, v61
    v_cvt_pk_bf16_f32 v85, v62, v63
    v_lshlrev_b32 v60, 16, v84
    v_and_b32 v61, 0xffff0000, v84
    v_lshlrev_b32 v62, 16, v85
    v_and_b32 v63, 0xffff0000, v85
    v_mul_f32 v60, s31, v60
    v_mul_f32 v61, s31, v61
    v_mul_f32 v62, s31, v62
    v_mul_f32 v63, s31, v63
    v_cvt_pk_bf16_f32 v84, v60, v61
    v_cvt_pk_bf16_f32 v85, v62, v63
    v_lshlrev_b32 v60, 16, v84
    v_and_b32 v61, 0xffff0000, v84
    v_lshlrev_b32 v62, 16, v85
    v_and_b32 v63, 0xffff0000, v85
    v_max3_f32 v86, v60, v61, v62
    v_max_f32 v86, v86, v63
    v_mov_b32 v87, v86
    s_nop 1
    v_permlane16_swap_b32 v86, v87
    v_max_f32 v86, v86, v87
    v_mov_b32 v87, v86
    s_nop 1
    v_permlane32_swap_b32 v86, v87
    v_max_f32 v86, v86, v87
    s_mov_b64 exec, 15
    ds_max_f32 v104, v86 offset:3472
    s_mov_b64 exec, 1
    ds_add_u32 v9, v11 offset:3464
    s_mov_b64 exec, -1
    s_mov_b32 s38, 0
L_spin6:
    ds_read_b128 v[72:75], v9 offset:3456
    ds_read_b32 v86, v104 offset:3472
    s_waitcnt lgkmcnt(0)
    v_cmp_gt_u32 vcc, 16, v74
    s_add_u32 s38, s38, 1
    s_cmp_gt_u32 s38, 200000
    s_cbranch_scc1 L_spin6_x
    s_cbranch_vccnz L_spin6
L_spin6_x:
    v_readfirstlane_b32 s42, v90
    s_mov_b32 s31, 0x3fb8aa3b
    v_mul_f32 v86, s31, v86
    v_fma_f32 v60, v60, s31, -v86
    v_fma_f32 v61, v61, s31, -v86
    v_fma_f32 v62, v62, s31, -v86
    v_fma_f32 v63, v63, s31, -v86
    v_exp_f32 v60, v60
    v_exp_f32 v61, v61
    v_exp_f32 v62, v62
    v_exp_f32 v63, v63
    s_nop 0
    v_cvt_pk_bf16_f32 v84, v60, v61
    v_cvt_pk_bf16_f32 v85, v62, v63
    v_add_f32 v88, v60, v61
    v_add_f32 v3, v62, v63
    s_mov_b32 exec_lo, 0x000f000f
    s_mov_b32 exec_hi, 0x000f000f
    ds_write_b64 v105, v[84:85]
    s_mov_b64 exec, -1
    v_add_f32 v88, v88, v3
    v_mov_b32 v87, v88
    s_nop 1
    v_permlane16_swap_b32 v88, v87
    v_add_f32 v88, v88, v87
    v_mov_b32 v87, v88
    s_nop 1
    v_permlane32_swap_b32 v88, v87
    v_add_f32 v88, v88, v87
    s_mov_b64 exec, 15
    ds_write_b32 v107, v88
    s_mov_b64 exec, 1
    ds_add_u32 v9, v11 offset:3468
    s_mov_b64 exec, -1
    s_mov_b32 s38, 0
L_spin7:
    ds_read_b128 v[72:75], v9 offset:3456
    s_waitcnt lgkmcnt(0)
    v_cmp_gt_u32 vcc, 8, v75
    s_add_u32 s38, s38, 1
    s_cmp_gt_u32 s38, 200000
    s_cbranch_scc1 L_spin7_x
    s_cbranch_vccnz L_spin7
L_spin7_x:
    ds_read_b128 v[28:31], v106 offset:2304
    ds_read_b128 v[32:35], v106 offset:2560
    ds_read_b128 v[36:39], v106 offset:2816
    ds_read_b128 v[40:43], v106 offset:3072
    ds_read_b128 v[44:47], v108 offset:3328
    ds_read_b128 v[48:51], v108 offset:3344
    s_waitcnt lgkmcnt(0)
    v_add_f32 v44, v44, v45
    v_add_f32 v46, v46, v47
    v_add_f32 v48, v48, v49
    v_add_f32 v50, v50, v51
    v_add_f32 v44, v44, v46
    v_add_f32 v48, v48, v50
    v_add_f32 v88, v44, v48
    v_rcp_f32 v87, v88
    v_log_f32 v6, v88
    v_cmp_gt_u32 s[40:41], 4, v8
    v_add_f32 v86, v86, v6
    v_perm_b32 v52, v86, v10, s96
    v_perm_b32 v53, v86, v10, s97
    v_perm_b32 v54, v86, v10, s98
    v_perm_b32 v55, v86, v10, s99
    s_mov_b32 s38, 0
L_spin8:
    ds_read_b128 v[72:75], v9 offset:3456
    s_waitcnt lgkmcnt(0)
    v_cmp_gt_u32 vcc, 5, v72
    s_add_u32 s38, s38, 1
    s_cmp_gt_u32 s38, 200000
    s_cbranch_scc1 L_spin8_x
    s_cbranch_vccnz L_spin8
L_spin8_x:
    ds_read_b64_tr_b16 v[12:13], v109 offset:0
    ds_read_b64_tr_b16 v[14:15], v109 offset:4096
    ds_read_b64_tr_b16 v[16:17], v109 offset:8192
    ds_read_b64_tr_b16 v[18:19], v109 offset:12288
    ds_read_b64_tr_b16 v[20:21], v109 offset:16384
    ds_read_b64_tr_b16 v[22:23], v109 offset:20480
    ds_read_b64_tr_b16 v[24:25], v109 offset:24576
    ds_read_b64_tr_b16 v[26:27], v109 offset:28672
    s_waitcnt lgkmcnt(6)
    v_mfma_f32_16x16x32_bf16 v[60:63], v[12:15], v[28:31], 0
    s_waitcnt lgkmcnt(4)
    v_mfma_f32_16x16x32_bf16 v[60:63], v[16:19], v[32:35], v[60:63]
    s_waitcnt lgkmcnt(2)
    v_mfma_f32_16x16x32_bf16 v[60:63], v[20:23], v[36:39], v[60:63]
    s_waitcnt lgkmcnt(0)
    v_mfma_f32_16x16x32_bf16 v[60:63], v[24:27], v[40:43], v[60:63]
    s_cmp_eq_u32 s3, 2
    s_cbranch_scc0 L_nolse
    s_mov_b64 exec, 15
    s_cmp_eq_u32 s42, 1
    s_cbranch_scc1 L_st9_f
    global_store_dwordx4 v111, v[52:55], s[26:27] offset:2048 sc1
    s_branch L_st9_x
L_st9_f:
    global_store_dwordx4 v111, v[52:55], s[26:27] offset:2048
L_st9_x:
    s_mov_b64 exec, -1
L_nolse:
    s_nop 5
    v_mul_f32 v60, v60, v87
    v_mul_f32 v61, v61, v87
    v_mul_f32 v62, v62, v87
    v_mul_f32 v63, v63, v87
    v_perm_b32 v68, v60, v10, s96
    v_perm_b32 v69, v61, v10, s97
    v_perm_b32 v70, v62, v10, s98
    v_perm_b32 v71, v63, v10, s99
    s_mov_b64 exec, s[40:41]
    s_cmp_eq_u32 s42, 1
    s_cbranch_scc1 L_st10_f
    global_store_dwordx4 v110, v[68:71], s[26:27] sc1
    s_branch L_st10_x
L_st10_f:
    global_store_dwordx4 v110, v[68:71], s[26:27]
L_st10_x:
    s_mov_b64 exec, -1
    s_cmp_ge_u32 s3, 4
    s_cbranch_scc0 L_nogu
    s_cmp_lt_u32 s100, 28
    s_cbranch_scc0 L_nogu
    ds_read2_b64 v[76:79], v96 offset0:0 offset1:4
    ds_read2_b64 v[80:83], v96 offset0:8 offset1:12
    s_mov_b32 s38, 0
L_spin11:
    ds_read_b128 v[72:75], v9 offset:3456
    s_waitcnt lgkmcnt(0)
    v_cmp_gt_u32 vcc, 6, v72
    s_add_u32 s38, s38, 1
    s_cmp_gt_u32 s38, 200000
    s_cbranch_scc1 L_spin11_x
    s_cbranch_vccnz L_spin11
L_spin11_x:
    ds_read_b64_tr_b16 v[12:13], v95 offset:0
    ds_read_b64_tr_b16 v[14:15], v95 offset:2048
    ds_read_b64_tr_b16 v[16:17], v95 offset:4096
    ds_read_b64_tr_b16 v[18:19], v95 offset:6144
    ds_read_b64_tr_b16 v[20:21], v95 offset:8192
    ds_read_b64_tr_b16 v[22:23], v95 offset:10240
    ds_read_b64_tr_b16 v[24:25], v95 offset:12288
    ds_read_b64_tr_b16 v[26:27], v95 offset:14336
    v_cmp_eq_u32 vcc, 1, v8
    v_cmp_gt_u32 s[32:33], 2, v8
    s_waitcnt lgkmcnt(6)
    v_mfma_f32_16x16x32_bf16 v[60:63], v[12:15], v[76:79], 0
    s_waitcnt lgkmcnt(4)
    v_mfma_f32_16x16x32_bf16 v[60:63], v[16:19], v[80:83], v[60:63]
    s_waitcnt lgkmcnt(2)
    v_mfma_f32_16x16x32_bf16 v[64:67], v[20:23], v[76:79], 0
    s_waitcnt lgkmcnt(0)
    v_mfma_f32_16x16x32_bf16 v[64:67], v[24:27], v[80:83], v[64:67]
    s_nop 7
    v_cndmask_b32 v60, v60, v64, vcc
    v_cndmask_b32 v61, v61, v65, vcc
    v_cndmask_b32 v62, v62, v66, vcc
    v_cndmask_b32 v63, v63, v67, vcc
    v_perm_b32 v68, v60, v10, s96
    v_perm_b32 v69, v61, v10, s97
    v_perm_b32 v70, v62, v10, s98
    v_perm_b32 v71, v63, v10, s99
    s_mov_b64 exec, s[32:33]
    s_cmp_eq_u32 s42, 1
    s_cbranch_scc1 L_st12_f
    global_store_dwordx4 v116, v[68:71], s[26:27] sc1
    s_branch L_st12_x
L_st12_f:
    global_store_dwordx4 v116, v[68:71], s[26:27]
L_st12_x:
    s_mov_b64 exec, -1
L_nogu:
    s_cmp_lt_u32 s3, 4
    s_cbranch_scc0 L_t_join
    s_mov_b32 s38, 0
    s_branch L_spin13_e
L_spin13:
    s_sleep 1
L_spin13_e:
    ds_read_b128 v[72:75], v9 offset:3456
    s_waitcnt lgkmcnt(0)
    v_cmp_gt_u32 vcc, 7, v72
    s_add_u32 s38, s38, 1
    s_cmp_gt_u32 s38, 200000
    s_cbranch_scc1 L_spin13_x
    s_cbranch_vccnz L_spin13
L_spin13_x:
    global_load_dwordx4 v[44:47], v112, s[26:27] sc1
    global_load_dwordx4 v[48:51], v113, s[26:27] sc1
    global_load_dwordx4 v[52:55], v114, s[26:27] sc1
    global_load_dwordx4 v[56:59], v115, s[26:27] sc1
L_t_join:
    s_mov_b32 s38, 0
L_spin14:
    ds_read_b128 v[72:75], v9 offset:3456
    s_waitcnt lgkmcnt(0)
    v_cmp_gt_u32 vcc, 8, v72
    s_add_u32 s38, s38, 1
    s_cmp_gt_u32 s38, 200000
    s_cbranch_scc1 L_spin14_x
    s_cbranch_vccnz L_spin14
L_spin14_x:
    ds_read_b64_tr_b16 v[12:13], v118 offset:0
    ds_read_b64_tr_b16 v[14:15], v118 offset:4096
    ds_read_b64_tr_b16 v[16:17], v118 offset:8192
    ds_read_b64_tr_b16 v[18:19], v118 offset:12288
    ds_read_b64_tr_b16 v[128:129], v118 offset:16384
    ds_read_b64_tr_b16 v[130:131], v118 offset:20480
    s_cmp_lt_u32 s3, 4
    s_cbranch_scc0 L_c_join
    s_mov_b32 s37, 0
L_poll15:
    s_waitcnt vmcnt(0)
    v_perm_b32 v3, v45, v44, s95
    v_perm_b32 v4, v47, v46, s95
    v_perm_b32 v3, v4, v3, s94
    v_xor_b32 v5, v3, v10
    v_perm_b32 v3, v49, v48, s95
    v_perm_b32 v4, v51, v50, s95
    v_perm_b32 v3, v4, v3, s94
    v_xor_b32 v3, v3, v10
    v_or_b32 v5, v5, v3
    v_perm_b32 v3, v53, v52, s95
    v_perm_b32 v4, v55, v54, s95
    v_perm_b32 v3, v4, v3, s94
    v_xor_b32 v3, v3, v10
    v_or_b32 v5, v5, v3
    v_perm_b32 v3, v57, v56, s95
    v_perm_b32 v4, v59, v58, s95
    v_perm_b32 v3, v4, v3, s94
    v_xor_b32 v3, v3, v10
    v_or_b32 v5, v5, v3
    v_cmp_ne_u32 vcc, 0, v5
    s_cbranch_vccz L_poll15_x
    s_add_u32 s37, s37, 1
    s_cmp_gt_u32 s37, 200000
    s_cbranch_scc1 L_poll15_x
    s_mov_b64 exec, vcc
    global_load_dwordx4 v[44:47], v112, s[26:27] sc1
    global_load_dwordx4 v[48:51], v113, s[26:27] sc1
    global_load_dwordx4 v[52:55], v114, s[26:27] sc1
    global_load_dwordx4 v[56:59], v115, s[26:27] sc1
    s_branch L_poll15
L_poll15_x:
    s_mov_b64 exec, -1
    v_and_b32 v44, 0xffffff00, v44
    v_and_b32 v45, 0xffffff00, v45
    v_and_b32 v46, 0xffffff00, v46
    v_and_b32 v47, 0xffffff00, v47
    v_and_b32 v48, 0xffffff00, v48
    v_and_b32 v49, 0xffffff00, v49
    v_and_b32 v50, 0xffffff00, v50
    v_and_b32 v51, 0xffffff00, v51
    v_and_b32 v52, 0xffffff00, v52
    v_and_b32 v56, 0xffffff00, v56
    v_max_f32 v86, v52, v56
    s_nop 1
    v_max_f32_dpp v86, v86, v86 row_ror:4 row_mask:0xf bank_mask:0xf
    s_nop 1
    v_max_f32_dpp v86, v86, v86 row_ror:8 row_mask:0xf bank_mask:0xf
    v_mov_b32 v87, v86
    s_nop 1
    v_permlane16_swap_b32 v86, v87
    v_max_f32 v86, v86, v87
    v_mov_b32 v87, v86
    s_nop 1
    v_permlane32_swap_b32 v86, v87
    v_max_f32 v86, v86, v87
    v_sub_f32 v52, v52, v86
    v_sub_f32 v56, v56, v86
    v_exp_f32 v52, v52
    v_exp_f32 v56, v56
    s_nop 0
    v_add_f32 v88, v52, v56
    v_mul_f32 v44, v44, v52
    v_fmac_f32 v44, v48, v56
    v_mul_f32 v45, v45, v52
    v_fmac_f32 v45, v49, v56
    v_mul_f32 v46, v46, v52
    v_fmac_f32 v46, v50, v56
    v_mul_f32 v47, v47, v52
    v_fmac_f32 v47, v51, v56
    v_add_f32_dpp v88, v88, v88 row_ror:4 row_mask:0xf bank_mask:0xf
    v_add_f32_dpp v44, v44, v44 row_ror:4 row_mask:0xf bank_mask:0xf
    v_add_f32_dpp v45, v45, v45 row_ror:4 row_mask:0xf bank_mask:0xf
    v_add_f32_dpp v46, v46, v46 row_ror:4 row_mask:0xf bank_mask:0xf
    v_add_f32_dpp v47, v47, v47 row_ror:4 row_mask:0xf bank_mask:0xf
    v_add_f32_dpp v88, v88, v88 row_ror:8 row_mask:0xf bank_mask:0xf
    v_add_f32_dpp v44, v44, v44 row_ror:8 row_mask:0xf bank_mask:0xf
    v_add_f32_dpp v45, v45, v45 row_ror:8 row_mask:0xf bank_mask:0xf
    v_add_f32_dpp v46, v46, v46 row_ror:8 row_mask:0xf bank_mask:0xf
    v_add_f32_dpp v47, v47, v47 row_ror:8 row_mask:0xf bank_mask:0xf
    v_mov_b32 v87, v88
    s_nop 0
    v_permlane32_swap_b32 v44, v45
    v_permlane32_swap_b32 v46, v47
    v_permlane32_swap_b32 v88, v87
    v_add_f32 v44, v44, v45
    v_add_f32 v46, v46, v47
    v_add_f32 v88, v88, v87
    v_mov_b32 v87, v88
    s_nop 0
    v_permlane16_swap_b32 v44, v46
    s_nop 0
    v_permlane16_swap_b32 v88, v87
    v_add_f32 v44, v44, v46
    v_add_f32 v88, v88, v87
    v_rcp_f32 v88, v88
    s_nop 0
    v_mul_f32 v44, v44, v88
    v_cvt_pk_bf16_f32 v44, v44, v44
    s_mov_b32 exec_lo, 0x000f000f
    s_mov_b32 exec_hi, 0x000f000f
    ds_write_b16 v120, v44
    s_mov_b64 exec, -1
L_c_join:
    s_waitcnt lgkmcnt(0)
    s_barrier
    ds_read_b128 v[28:31], v119 offset:0
    ds_read_b128 v[32:35], v119 offset:64
    ds_read_b128 v[36:39], v119 offset:128
    v_cmp_eq_u32 s[32:33], 0, v8
    s_waitcnt lgkmcnt(2)
    v_mfma_f32_16x16x32_bf16 v[60:63], v[12:15], v[28:31], 0
    s_waitcnt lgkmcnt(1)
    v_mfma_f32_16x16x32_bf16 v[60:63], v[16:19], v[32:35], v[60:63]
    s_waitcnt lgkmcnt(0)
    v_mfma_f32_16x16x32_bf16 v[60:63], v[128:131], v[36:39], v[60:63]
    s_nop 7
    v_perm_b32 v68, v60, v10, s96
    v_perm_b32 v69, v61, v10, s97
    v_perm_b32 v70, v62, v10, s98
    v_perm_b32 v71, v63, v10, s99
    s_mov_b64 exec, s[32:33]
    global_store_dwordx4 v121, v[68:71], s[26:27] sc1
    s_mov_b64 exec, -1
    s_barrier
    s_branch L_fin
L_loader:
    s_setprio 3
    v_and_b32 v3, 3, v7
    v_lshlrev_b32 v3, 1, v3
    v_and_b32 v4, 7, v1
    v_xor_b32 v4, v4, v3
    v_lshlrev_b32 v12, 4, v4
    v_lshrrev_b32 v5, 3, v1
    v_lshlrev_b32 v6, 13, v5
    v_add_u32 v13, v6, v12
    v_mul_u32_u24 v6, 3584, v5
    v_add_u32 v14, v6, v12
    s_lshr_b32 s31, s29, 3
    s_lshl_b32 s31, s31, 20
    s_lshl_b32 s32, s28, 10
    s_add_u32 s31, s31, s32
    s_and_b32 s32, s29, 7
    s_lshl_b32 s32, s32, 7
    s_add_u32 s31, s31, s32
    v_add_u32 v13, s31, v13
    s_waitcnt lgkmcnt(0)
    s_mov_b32 s48, s10
    s_and_b32 s49, s11, 0xffff
    s_mov_b32 s50, 0x400000
    s_mov_b32 s51, 0x20000
    s_mov_b32 m0, 4096
    s_mov_b32 s33, 0
    buffer_load_dwordx4 v13, s[48:51], s33 offen nt lds
    s_mov_b32 m0, 5120
    s_mov_b32 s33, 65536
    buffer_load_dwordx4 v13, s[48:51], s33 offen nt lds
    s_mov_b32 m0, 6144
    s_mov_b32 s33, 131072
    buffer_load_dwordx4 v13, s[48:51], s33 offen nt lds
    s_mov_b32 m0, 7168
    s_mov_b32 s33, 196608
    buffer_load_dwordx4 v13, s[48:51], s33 offen nt lds
    s_mov_b32 m0, 8192
    s_mov_b32 s33, 262144
    buffer_load_dwordx4 v13, s[48:51], s33 offen nt lds
    s_mov_b32 m0, 9216
    s_mov_b32 s33, 327680
    buffer_load_dwordx4 v13, s[48:51], s33 offen nt lds
    s_mov_b32 m0, 10240
    s_mov_b32 s33, 393216
    buffer_load_dwordx4 v13, s[48:51], s33 offen nt lds
    s_mov_b32 m0, 11264
    s_mov_b32 s33, 458752
    buffer_load_dwordx4 v13, s[48:51], s33 offen nt lds
    s_mov_b32 m0, 12288
    s_mov_b32 s33, 524288
    buffer_load_dwordx4 v13, s[48:51], s33 offen nt lds
    s_mov_b32 m0, 13312
    s_mov_b32 s33, 589824
    buffer_load_dwordx4 v13, s[48:51], s33 offen nt lds
    s_mov_b32 m0, 14336
    s_mov_b32 s33, 655360
    buffer_load_dwordx4 v13, s[48:51], s33 offen nt lds
    s_mov_b32 m0, 15360
    s_mov_b32 s33, 720896
    buffer_load_dwordx4 v13, s[48:51], s33 offen nt lds
    s_mov_b32 m0, 16384
    s_mov_b32 s33, 786432
    buffer_load_dwordx4 v13, s[48:51], s33 offen nt lds
    s_mov_b32 m0, 17408
    s_mov_b32 s33, 851968
    buffer_load_dwordx4 v13, s[48:51], s33 offen nt lds
    s_mov_b32 m0, 18432
    s_mov_b32 s33, 917504
    buffer_load_dwordx4 v13, s[48:51], s33 offen nt lds
    s_mov_b32 m0, 19456
    s_mov_b32 s33, 983040
    buffer_load_dwordx4 v13, s[48:51], s33 offen nt lds
    s_mov_b32 s40, s6
    s_and_b32 s41, s7, 0xffff
    s_mov_b32 s42, 0x4000000
    s_mov_b32 s43, 0x20000
    s_mov_b32 s44, s8
    s_and_b32 s45, s9, 0xffff
    s_mov_b32 s46, 0x4000000
    s_mov_b32 s47, 0x20000
    s_lshl_b32 s31, s28, 23
    s_lshl_b32 s32, s29, 15
    s_add_u32 s31, s31, s32
    s_add_u32 s31, s31, 7340032
    v_lshlrev_b32 v3, 8, v7
    v_add_u32 v3, s31, v3
    v_xor_b32 v4, v8, v7
    v_xor_b32 v5, 0, v4
    v_lshl_add_u32 v16, v5, 4, v3
    v_xor_b32 v5, 4, v4
    v_lshl_add_u32 v17, v5, 4, v3
    v_xor_b32 v5, 8, v4
    v_lshl_add_u32 v18, v5, 4, v3
    v_xor_b32 v5, 12, v4
    v_lshl_add_u32 v19, v5, 4, v3
    v_lshlrev_b32 v4, 1, v7
    v_xor_b32 v4, v8, v4
    v_xor_b32 v5, 0, v4
    v_lshl_add_u32 v20, v5, 4, v3
    v_xor_b32 v5, 8, v4
    v_lshl_add_u32 v21, v5, 4, v3
    s_barrier
    s_mov_b32 m0, 36864
    s_mov_b32 s33, 0
    buffer_load_dwordx4 v16, s[40:43], s33 offen offset:0 nt lds
    s_waitcnt vmcnt(16)
    buffer_load_dwordx4 v17, s[40:43], s33 offen offset:1024 nt lds
    s_waitcnt vmcnt(16)
    buffer_load_dwordx4 v18, s[40:43], s33 offen offset:2048 nt lds
    s_waitcnt vmcnt(16)
    buffer_load_dwordx4 v19, s[40:43], s33 offen offset:3072 nt lds
    s_waitcnt vmcnt(16)
    s_mov_b32 m0, 40960
    s_mov_b32 s33, 4096
    buffer_load_dwordx4 v16, s[40:43], s33 offen offset:0 nt lds
    s_waitcnt vmcnt(16)
    buffer_load_dwordx4 v17, s[40:43], s33 offen offset:1024 nt lds
    s_waitcnt vmcnt(16)
    buffer_load_dwordx4 v18, s[40:43], s33 offen offset:2048 nt lds
    s_waitcnt vmcnt(16)
    buffer_load_dwordx4 v19, s[40:43], s33 offen offset:3072 nt lds
    s_waitcnt vmcnt(16)
    s_mov_b32 m0, 45056
    s_mov_b32 s33, 8192
    buffer_load_dwordx4 v16, s[40:43], s33 offen offset:0 nt lds
    s_waitcnt vmcnt(16)
    buffer_load_dwordx4 v17, s[40:43], s33 offen offset:1024 nt lds
    s_waitcnt vmcnt(16)
    buffer_load_dwordx4 v18, s[40:43], s33 offen offset:2048 nt lds
    s_waitcnt vmcnt(16)
    buffer_load_dwordx4 v19, s[40:43], s33 offen offset:3072 nt lds
    s_waitcnt vmcnt(16)
    s_mov_b32 m0, 49152
    s_mov_b32 s33, 12288
    buffer_load_dwordx4 v16, s[40:43], s33 offen offset:0 nt lds
    s_waitcnt vmcnt(16)
    buffer_load_dwordx4 v17, s[40:43], s33 offen offset:1024 nt lds
    s_waitcnt vmcnt(16)
    buffer_load_dwordx4 v18, s[40:43], s33 offen offset:2048 nt lds
    s_waitcnt vmcnt(16)
    buffer_load_dwordx4 v19, s[40:43], s33 offen offset:3072 nt lds
    s_waitcnt vmcnt(16)
    v_mov_b32 v24, 1
    ds_write_b32 v9, v24 offset:3456
    s_mov_b32 m0, 53248
    s_mov_b32 s33, 16384
    buffer_load_dwordx4 v16, s[40:43], s33 offen offset:0 nt lds
    s_mov_b32 s56, s16
    s_and_b32 s57, s17, 0xffff
    s_mov_b32 s58, 0x1c0000
    s_mov_b32 s59, 0x20000
    s_mov_b32 s60, s18
    s_and_b32 s61, s19, 0xffff
    s_mov_b32 s62, 0x1c0000
    s_mov_b32 s63, 0x20000
    s_and_b32 s31, s29, 7
    s_lshl_b32 s31, s31, 6
    s_waitcnt vmcnt(16)
    buffer_load_dwordx4 v17, s[40:43], s33 offen offset:1024 nt lds
    s_mul_i32 s31, s31, 3584
    s_lshl_b32 s32, s100, 7
    s_add_u32 s31, s31, s32
    s_cmp_ge_u32 s100, 28
    s_cselect_b32 s32, 0x40000000, 0
    s_add_u32 s31, s31, s32
    v_add_u32 v14, s31, v14
    s_mov_b32 s52, s12
    s_and_b32 s53, s13, 0xffff
    s_mov_b32 s54, 0x400000
    s_waitcnt vmcnt(16)
    buffer_load_dwordx4 v18, s[40:43], s33 offen offset:2048 nt lds
    s_mov_b32 s55, 0x20000
    s_mov_b32 s64, s20
    s_and_b32 s65, s21, 0xffff
    s_mov_b32 s66, 0x1c0000
    s_mov_b32 s67, 0x20000
    s_lshr_b32 s34, s29, 2
    s_and_b32 s35, s29, 3
    s_lshl_b32 s36, s28, 19
    s_lshl_b32 s32, s34, 16
    s_add_u32 s36, s36, s32
    s_waitcnt vmcnt(16)
    buffer_load_dwordx4 v19, s[40:43], s33 offen offset:3072 nt lds
    s_lshl_b32 s32, s35, 8
    s_add_u32 s36, s36, s32
    s_lshl_b32 s39, s100, 1
    s_bfe_u32 s38, s29, 0x10002
    s_add_u32 s39, s39, s38
    s_lshl_b32 s37, s39, 15
    s_add_u32 s37, s37, s32
    s_cmp_ge_u32 s100, 28
    s_cselect_b32 s32, 0x40000000, 0
    s_add_u32 s37, s37, s32
    s_waitcnt vmcnt(16)
    s_mov_b32 m0, 57344
    s_mov_b32 s33, 20480
    buffer_load_dwordx4 v16, s[40:43], s33 offen offset:0 nt lds
    v_lshlrev_b32 v3, 10, v7
    v_lshlrev_b32 v4, 1, v7
    v_xor_b32 v4, v8, v4
    v_xor_b32 v5, 0, v4
    v_lshl_add_u32 v22, v5, 4, v3
    v_xor_b32 v5, 8, v4
    v_lshl_add_u32 v23, v5, 4, v3
    s_mov_b64 exec, 1
    buffer_load_dword v126, v20, s[44:47], 0 offen nt
    buffer_load_dword v126, v22, s[52:55], s36 offen nt
    buffer_load_dword v126, v22, s[64:67], s37 offen nt
    s_mov_b64 exec, -1
    s_waitcnt vmcnt(16)
    buffer_load_dwordx4 v17, s[40:43], s33 offen offset:1024 nt lds
    s_waitcnt vmcnt(16)
    buffer_load_dwordx4 v18, s[40:43], s33 offen offset:2048 nt lds
    s_waitcnt vmcnt(16)
    buffer_load_dwordx4 v19, s[40:43], s33 offen offset:3072 nt lds
    s_waitcnt vmcnt(16)
    s_mov_b32 m0, 61440
    s_mov_b32 s33, 24576
    buffer_load_dwordx4 v16, s[40:43], s33 offen offset:0 nt lds
    s_waitcnt vmcnt(16)
    buffer_load_dwordx4 v17, s[40:43], s33 offen offset:1024 nt lds
    s_waitcnt vmcnt(16)
    buffer_load_dwordx4 v18, s[40:43], s33 offen offset:2048 nt lds
    s_waitcnt vmcnt(16)
    buffer_load_dwordx4 v19, s[40:43], s33 offen offset:3072 nt lds
    s_waitcnt vmcnt(16)
    s_mov_b32 m0, 65536
    s_mov_b32 s33, 28672
    buffer_load_dwordx4 v16, s[40:43], s33 offen offset:0 nt lds
    s_waitcnt vmcnt(16)
    buffer_load_dwordx4 v17, s[40:43], s33 offen offset:1024 nt lds
    s_waitcnt vmcnt(16)
    buffer_load_dwordx4 v18, s[40:43], s33 offen offset:2048 nt lds
    s_waitcnt vmcnt(16)
    buffer_load_dwordx4 v19, s[40:43], s33 offen offset:3072 nt lds
    s_waitcnt vmcnt(16)
    s_mov_b32 m0, 69632
    s_mov_b32 s33, 0
    buffer_load_dwordx4 v20, s[44:47], s33 offen offset:0 nt lds
    s_waitcnt vmcnt(16)
    v_mov_b32 v24, 2
    ds_write_b32 v9, v24 offset:3456
    buffer_load_dwordx4 v21, s[44:47], s33 offen offset:1024 nt lds
    s_waitcnt vmcnt(16)
    buffer_load_dwordx4 v20, s[44:47], s33 offen offset:2048 nt lds
    s_waitcnt vmcnt(16)
    buffer_load_dwordx4 v21, s[44:47], s33 offen offset:3072 nt lds
    s_waitcnt vmcnt(16)
    s_mov_b32 m0, 73728
    s_mov_b32 s33, 4096
    buffer_load_dwordx4 v20, s[44:47], s33 offen offset:0 nt lds
    s_waitcnt vmcnt(16)
    buffer_load_dwordx4 v21, s[44:47], s33 offen offset:1024 nt lds
    s_waitcnt vmcnt(16)
    buffer_load_dwordx4 v20, s[44:47], s33 offen offset:2048 nt lds
    s_waitcnt vmcnt(16)
    buffer_load_dwordx4 v21, s[44:47], s33 offen offset:3072 nt lds
    s_waitcnt vmcnt(16)
    s_mov_b32 m0, 77824
    s_mov_b32 s33, 8192
    buffer_load_dwordx4 v20, s[44:47], s33 offen offset:0 nt lds
    s_waitcnt vmcnt(16)
    buffer_load_dwordx4 v21, s[44:47], s33 offen offset:1024 nt lds
    s_waitcnt vmcnt(16)
    buffer_load_dwordx4 v20, s[44:47], s33 offen offset:2048 nt lds
    s_waitcnt vmcnt(16)
    buffer_load_dwordx4 v21, s[44:47], s33 offen offset:3072 nt lds
    s_waitcnt vmcnt(16)
    s_mov_b32 m0, 81920
    s_mov_b32 s33, 12288
    buffer_load_dwordx4 v20, s[44:47], s33 offen offset:0 nt lds
    s_waitcnt vmcnt(16)
    buffer_load_dwordx4 v21, s[44:47], s33 offen offset:1024 nt lds
    s_waitcnt vmcnt(16)
    buffer_load_dwordx4 v20, s[44:47], s33 offen offset:2048 nt lds
    s_waitcnt vmcnt(16)
    buffer_load_dwordx4 v21, s[44:47], s33 offen offset:3072 nt lds
    s_waitcnt vmcnt(16)
    v_mov_b32 v24, 3
    ds_write_b32 v9, v24 offset:3456
    s_mov_b32 m0, 86016
    s_mov_b32 s33, 16384
    buffer_load_dwordx4 v20, s[44:47], s33 offen offset:0 nt lds
    s_waitcnt vmcnt(20)
    buffer_load_dwordx4 v21, s[44:47], s33 offen offset:1024 nt lds
    s_waitcnt vmcnt(20)
    buffer_load_dwordx4 v20, s[44:47], s33 offen offset:2048 nt lds
    s_waitcnt vmcnt(20)
    buffer_load_dwordx4 v21, s[44:47], s33 offen offset:3072 nt lds
    s_waitcnt vmcnt(20)
    s_mov_b32 m0, 90112
    s_mov_b32 s33, 20480
    buffer_load_dwordx4 v20, s[44:47], s33 offen offset:0 nt lds
    s_waitcnt vmcnt(20)
    buffer_load_dwordx4 v21, s[44:47], s33 offen offset:1024 nt lds
    s_waitcnt vmcnt(20)
    buffer_load_dwordx4 v20, s[44:47], s33 offen offset:2048 nt lds
    s_waitcnt vmcnt(20)
    buffer_load_dwordx4 v21, s[44:47], s33 offen offset:3072 nt lds
    s_waitcnt vmcnt(20)
    s_mov_b32 m0, 94208
    s_mov_b32 s33, 24576
    buffer_load_dwordx4 v20, s[44:47], s33 offen offset:0 nt lds
    s_waitcnt vmcnt(20)
    buffer_load_dwordx4 v21, s[44:47], s33 offen offset:1024 nt lds
    s_waitcnt vmcnt(20)
    buffer_load_dwordx4 v20, s[44:47], s33 offen offset:2048 nt lds
    s_waitcnt vmcnt(20)
    buffer_load_dwordx4 v21, s[44:47], s33 offen offset:3072 nt lds
    s_waitcnt vmcnt(20)
    s_mov_b32 m0, 98304
    s_mov_b32 s33, 28672
    buffer_load_dwordx4 v20, s[44:47], s33 offen offset:0 nt lds
    s_waitcnt vmcnt(20)
    buffer_load_dwordx4 v21, s[44:47], s33 offen offset:1024 nt lds
    s_waitcnt vmcnt(20)
    buffer_load_dwordx4 v20, s[44:47], s33 offen offset:2048 nt lds
    s_waitcnt vmcnt(20)
    buffer_load_dwordx4 v21, s[44:47], s33 offen offset:3072 nt lds
    s_waitcnt vmcnt(20)
    s_mov_b32 m0, 20480
    s_mov_b32 s33, 0
    buffer_load_dwordx4 v14, s[56:59], s33 offen nt lds
    s_waitcnt vmcnt(16)
    v_mov_b32 v24, 4
    ds_write_b32 v9, v24 offset:3456
    s_mov_b32 m0, 21504
    s_mov_b32 s33, 28672
    buffer_load_dwordx4 v14, s[56:59], s33 offen nt lds
    s_waitcnt vmcnt(16)
    s_mov_b32 m0, 22528
    s_mov_b32 s33, 57344
    buffer_load_dwordx4 v14, s[56:59], s33 offen nt lds
    s_waitcnt vmcnt(16)
    s_mov_b32 m0, 23552
    s_mov_b32 s33, 86016
    buffer_load_dwordx4 v14, s[56:59], s33 offen nt lds
    s_waitcnt vmcnt(16)
    s_mov_b32 m0, 24576
    s_mov_b32 s33, 114688
    buffer_load_dwordx4 v14, s[56:59], s33 offen nt lds
    s_waitcnt vmcnt(16)
    s_mov_b32 m0, 25600
    s_mov_b32 s33, 143360
    buffer_load_dwordx4 v14, s[56:59], s33 offen nt lds
    s_waitcnt vmcnt(16)
    s_mov_b32 m0, 26624
    s_mov_b32 s33, 172032
    buffer_load_dwordx4 v14, s[56:59], s33 offen nt lds
    s_waitcnt vmcnt(16)
    s_mov_b32 m0, 27648
    s_mov_b32 s33, 200704
    buffer_load_dwordx4 v14, s[56:59], s33 offen nt lds
    s_waitcnt vmcnt(16)
    s_mov_b32 m0, 28672
    s_mov_b32 s33, 0
    buffer_load_dwordx4 v14, s[60:63], s33 offen nt lds
    s_waitcnt vmcnt(16)
    s_mov_b32 m0, 29696
    s_mov_b32 s33, 28672
    buffer_load_dwordx4 v14, s[60:63], s33 offen nt lds
    s_waitcnt vmcnt(16)
    s_mov_b32 m0, 30720
    s_mov_b32 s33, 57344
    buffer_load_dwordx4 v14, s[60:63], s33 offen nt lds
    s_waitcnt vmcnt(16)
    s_mov_b32 m0, 31744
    s_mov_b32 s33, 86016
    buffer_load_dwordx4 v14, s[60:63], s33 offen nt lds
    s_waitcnt vmcnt(16)
    s_mov_b32 m0, 32768
    s_mov_b32 s33, 114688
    buffer_load_dwordx4 v14, s[60:63], s33 offen nt lds
    s_waitcnt vmcnt(16)
    s_mov_b32 m0, 33792
    s_mov_b32 s33, 143360
    buffer_load_dwordx4 v14, s[60:63], s33 offen nt lds
    s_waitcnt vmcnt(16)
    s_mov_b32 m0, 34816
    s_mov_b32 s33, 172032
    buffer_load_dwordx4 v14, s[60:63], s33 offen nt lds
    s_waitcnt vmcnt(16)
    s_mov_b32 m0, 35840
    s_mov_b32 s33, 200704
    buffer_load_dwordx4 v14, s[60:63], s33 offen nt lds
    s_waitcnt vmcnt(16)
    v_mov_b32 v24, 5
    ds_write_b32 v9, v24 offset:3456
    s_mov_b32 m0, 102400
    s_add_u32 s33, s36, 0
    buffer_load_dwordx4 v22, s[52:55], s33 offen nt lds
    s_waitcnt vmcnt(20)
    s_mov_b32 m0, 103424
    s_add_u32 s33, s36, 4096
    buffer_load_dwordx4 v23, s[52:55], s33 offen nt lds
    s_waitcnt vmcnt(20)
    s_mov_b32 m0, 104448
    s_add_u32 s33, s36, 8192
    buffer_load_dwordx4 v22, s[52:55], s33 offen nt lds
    s_waitcnt vmcnt(20)
    s_mov_b32 m0, 105472
    s_add_u32 s33, s36, 12288
    buffer_load_dwordx4 v23, s[52:55], s33 offen nt lds
    s_waitcnt vmcnt(20)
    s_mov_b32 m0, 106496
    s_add_u32 s33, s36, 16384
    buffer_load_dwordx4 v22, s[52:55], s33 offen nt lds
    s_waitcnt vmcnt(20)
    s_mov_b32 m0, 107520
    s_add_u32 s33, s36, 20480
    buffer_load_dwordx4 v23, s[52:55], s33 offen nt lds
    s_waitcnt vmcnt(20)
    s_mov_b32 m0, 108544
    s_add_u32 s33, s36, 24576
    buffer_load_dwordx4 v22, s[52:55], s33 offen nt lds
    s_waitcnt vmcnt(20)
    s_mov_b32 m0, 109568
    s_add_u32 s33, s36, 28672
    buffer_load_dwordx4 v23, s[52:55], s33 offen nt lds
    s_waitcnt vmcnt(20)
    s_mov_b32 m0, 110592
    s_add_u32 s33, s36, 32768
    buffer_load_dwordx4 v22, s[52:55], s33 offen nt lds
    s_waitcnt vmcnt(20)
    s_mov_b32 m0, 111616
    s_add_u32 s33, s36, 36864
    buffer_load_dwordx4 v23, s[52:55], s33 offen nt lds
    s_waitcnt vmcnt(20)
    s_mov_b32 m0, 112640
    s_add_u32 s33, s36, 40960
    buffer_load_dwordx4 v22, s[52:55], s33 offen nt lds
    s_waitcnt vmcnt(20)
    s_mov_b32 m0, 113664
    s_add_u32 s33, s36, 45056
    buffer_load_dwordx4 v23, s[52:55], s33 offen nt lds
    s_waitcnt vmcnt(20)
    s_mov_b32 m0, 114688
    s_add_u32 s33, s36, 49152
    buffer_load_dwordx4 v22, s[52:55], s33 offen nt lds
    s_waitcnt vmcnt(20)
    s_mov_b32 m0, 115712
    s_add_u32 s33, s36, 53248
    buffer_load_dwordx4 v23, s[52:55], s33 offen nt lds
    s_waitcnt vmcnt(20)
    s_mov_b32 m0, 116736
    s_add_u32 s33, s36, 57344
    buffer_load_dwordx4 v22, s[52:55], s33 offen nt lds
    s_waitcnt vmcnt(20)
    s_mov_b32 m0, 117760
    s_add_u32 s33, s36, 61440
    buffer_load_dwordx4 v23, s[52:55], s33 offen nt lds
    s_waitcnt vmcnt(20)
    s_mov_b32 m0, 118784
    s_add_u32 s33, s37, 0
    buffer_load_dwordx4 v22, s[64:67], s33 offen nt lds
    s_waitcnt vmcnt(20)
    s_mov_b32 m0, 119808
    s_add_u32 s33, s37, 4096
    buffer_load_dwordx4 v23, s[64:67], s33 offen nt lds
    s_waitcnt vmcnt(20)
    s_mov_b32 m0, 120832
    s_add_u32 s33, s37, 8192
    buffer_load_dwordx4 v22, s[64:67], s33 offen nt lds
    s_waitcnt vmcnt(20)
    s_mov_b32 m0, 121856
    s_add_u32 s33, s37, 12288
    buffer_load_dwordx4 v23, s[64:67], s33 offen nt lds
    s_waitcnt vmcnt(20)
    v_mov_b32 v24, 6
    ds_write_b32 v9, v24 offset:3456
    s_mov_b32 m0, 122880
    s_add_u32 s33, s37, 16384
    buffer_load_dwordx4 v22, s[64:67], s33 offen nt lds
    s_waitcnt vmcnt(20)
    s_mov_b32 m0, 123904
    s_add_u32 s33, s37, 20480
    buffer_load_dwordx4 v23, s[64:67], s33 offen nt lds
    s_waitcnt vmcnt(20)
    s_mov_b32 m0, 124928
    s_add_u32 s33, s37, 24576
    buffer_load_dwordx4 v22, s[64:67], s33 offen nt lds
    s_waitcnt vmcnt(20)
    s_mov_b32 m0, 125952
    s_add_u32 s33, s37, 28672
    buffer_load_dwordx4 v23, s[64:67], s33 offen nt lds
    s_waitcnt vmcnt(20)
    s_waitcnt vmcnt(6)
    v_mov_b32 v24, 7
    ds_write_b32 v9, v24 offset:3456
    s_waitcnt vmcnt(0)
    v_mov_b32 v24, 8
    ds_write_b32 v9, v24 offset:3456
    s_branch L_fin
L_aux:
    s_waitcnt lgkmcnt(0)
    s_barrier
    s_lshl_b32 s39, s100, 1
    s_bfe_u32 s38, s29, 0x10002
    s_add_u32 s39, s39, s38
    s_load_dword s30, s[26:27], 0
    s_mov_b32 s95, 0x0c0c0400
    s_mov_b32 s94, 0x05040100
    s_lshr_b32 s31, s39, 1
    s_lshl_b32 s31, s31, 12
    s_and_b32 s32, s39, 1
    s_lshl_b32 s32, s32, 7
    s_add_u32 s31, s31, s32
    s_add_u32 s31, s31, 73728
    v_and_b32 v3, 7, v1
    v_lshlrev_b32 v3, 9, v3
    v_lshrrev_b32 v4, 3, v1
    v_lshl_add_u32 v3, v4, 4, v3
    v_add_u32 v117, s31, v3
    v_and_b32 v5, 3, v4
    v_lshlrev_b32 v5, 4, v5
    v_lshrrev_b32 v4, 2, v4
    v_lshl_add_u32 v5, v4, 3, v5
    v_add_u32 v120, 3648, v5
    s_lshr_b32 s31, s28, 1
    s_lshl_b32 s31, s31, 12
    s_and_b32 s32, s28, 1
    s_lshl_b32 s32, s32, 4
    s_and_b32 s38, s29, 15
    s_add_u32 s32, s32, s38
    s_lshl_b32 s38, s32, 4
    s_add_u32 s31, s31, s38
    s_add_u32 s31, s31, 786432
    v_and_b32 v3, 7, v1
    v_lshlrev_b32 v3, 9, v3
    v_lshrrev_b32 v4, 3, v1
    v_lshl_add_u32 v3, v4, 14, v3
    v_add_u32 v122, s31, v3
    s_lshr_b32 s31, s28, 1
    s_lshl_b32 s31, s31, 8
    s_lshl_b32 s32, s32, 3
    s_add_u32 s31, s31, s32
    v_mov_b32 v123, s31
    global_load_dwordx2 v[124:125], v123, s[4:5]
    s_lshl_b32 s31, s29, 1
    v_bfe_u32 v4, v1, 1, 1
    v_add_u32 v4, s31, v4
    v_and_b32 v5, 7, v4
    v_lshlrev_b32 v5, 9, v5
    v_lshrrev_b32 v4, 3, v4
    v_lshl_add_u32 v5, v4, 14, v5
    v_and_b32 v4, 1, v1
    v_lshl_add_u32 v5, v4, 7, v5
    s_lshr_b32 s31, s28, 1
    s_lshl_b32 s31, s31, 12
    s_and_b32 s32, s28, 1
    s_lshl_b32 s32, s32, 8
    s_add_u32 s31, s31, s32
    s_add_u32 s31, s31, 786432
    v_add_u32 v127, s31, v5
    s_waitcnt lgkmcnt(0)
    s_mul_i32 s30, s30, 1664525
    s_add_u32 s30, s30, 1013904223
    v_mov_b32 v10, s30
    v_not_b32 v3, v10
    s_mov_b32 s31, 0x0c0c0c00
    v_perm_b32 v68, v3, v3, s31
    s_mov_b32 s31, 0x0c0c0c01
    v_perm_b32 v69, v3, v3, s31
    s_mov_b32 s31, 0x0c0c0c02
    v_perm_b32 v70, v3, v3, s31
    s_mov_b32 s31, 0x0c0c0c03
    v_perm_b32 v71, v3, v3, s31
    s_mul_i32 s31, s28, 73728
    s_mul_i32 s32, s29, 2304
    s_add_u32 s31, s31, s32
    s_add_u32 s31, s31, 196608
    v_add_u32 v4, s31, v2
    global_store_dwordx4 v4, v[68:71], s[26:27]
    global_store_dwordx4 v4, v[68:71], s[26:27] offset:1024
    s_mov_b64 exec, 0xff
    global_store_dwordx4 v4, v[68:71], s[26:27] offset:2048
    s_cmp_lt_u32 s100, 28
    s_cbranch_scc0 L_x_nopwf
    s_lshl_b32 s31, s100, 12
    s_and_b32 s32, s29, 7
    s_lshl_b32 s32, s32, 9
    s_add_u32 s31, s31, s32
    s_add_u32 s31, s31, 73728
    s_mov_b64 exec, -1
    v_add_u32 v4, s31, v2
    s_mov_b32 exec_hi, 0
    global_store_dwordx4 v4, v[68:71], s[26:27]
L_x_nopwf:
    s_mov_b64 exec, -1
    s_waitcnt vmcnt(0)
    v_mov_b32 v3, 8
    s_mov_b64 exec, 1
    ds_add_u32 v9, v3 offset:3464
    s_mov_b64 exec, -1
    s_mov_b32 s38, 0
    s_branch L_spin16_e
L_spin16:
    s_sleep 1
L_spin16_e:
    ds_read_b128 v[72:75], v9 offset:3456
    s_waitcnt lgkmcnt(0)
    v_cmp_gt_u32 vcc, 5, v72
    s_add_u32 s38, s38, 1
    s_cmp_gt_u32 s38, 200000
    s_cbranch_scc1 L_spin16_x
    s_cbranch_vccnz L_spin16
L_spin16_x:
    s_cmp_lt_u32 s29, 32
    s_mov_b64 exec, 15
    global_load_dword v126, v127, s[26:27] sc1
    s_mov_b64 exec, 1
    global_load_dword v126, v123, s[22:23]
    s_mov_b64 exec, -1
    s_cmp_lt_u32 s100, 28
    s_cbranch_scc0 L_x_nohf
    s_mov_b32 s38, 0
    s_branch L_spin17_e
L_spin17:
    s_sleep 1
L_spin17_e:
    ds_read_b128 v[72:75], v9 offset:3456
    s_waitcnt lgkmcnt(0)
    v_cmp_gt_u32 vcc, 7, v72
    s_add_u32 s38, s38, 1
    s_cmp_gt_u32 s38, 200000
    s_cbranch_scc1 L_spin17_x
    s_cbranch_vccnz L_spin17
L_spin17_x:
    s_mov_b32 s37, 0
    global_load_dwordx4 v[44:47], v117, s[26:27] sc1
    global_load_dwordx4 v[48:51], v117, s[26:27] offset:256 sc1
L_poll18:
    s_waitcnt vmcnt(0)
    v_perm_b32 v3, v45, v44, s95
    v_perm_b32 v4, v47, v46, s95
    v_perm_b32 v3, v4, v3, s94
    v_xor_b32 v5, v3, v10
    v_perm_b32 v3, v49, v48, s95
    v_perm_b32 v4, v51, v50, s95
    v_perm_b32 v3, v4, v3, s94
    v_xor_b32 v3, v3, v10
    v_or_b32 v5, v5, v3
    v_cmp_ne_u32 vcc, 0, v5
    s_cbranch_vccz L_poll18_x
    s_add_u32 s37, s37, 1
    s_cmp_gt_u32 s37, 200000
    s_cbranch_scc1 L_poll18_x
    s_mov_b64 exec, vcc
    global_load_dwordx4 v[44:47], v117, s[26:27] sc1
    global_load_dwordx4 v[48:51], v117, s[26:27] offset:256 sc1
    s_branch L_poll18
L_poll18_x:
    s_mov_b64 exec, -1
    v_and_b32 v44, 0xffffff00, v44
    v_and_b32 v45, 0xffffff00, v45
    v_and_b32 v46, 0xffffff00, v46
    v_and_b32 v47, 0xffffff00, v47
    v_and_b32 v48, 0xffffff00, v48
    v_and_b32 v49, 0xffffff00, v49
    v_and_b32 v50, 0xffffff00, v50
    v_and_b32 v51, 0xffffff00, v51
    v_add_f32_dpp v44, v44, v44 quad_perm:[1,0,3,2] row_mask:0xf bank_mask:0xf
    v_add_f32_dpp v45, v45, v45 quad_perm:[1,0,3,2] row_mask:0xf bank_mask:0xf
    v_add_f32_dpp v46, v46, v46 quad_perm:[1,0,3,2] row_mask:0xf bank_mask:0xf
    v_add_f32_dpp v47, v47, v47 quad_perm:[1,0,3,2] row_mask:0xf bank_mask:0xf
    v_add_f32_dpp v48, v48, v48 quad_perm:[1,0,3,2] row_mask:0xf bank_mask:0xf
    v_add_f32_dpp v49, v49, v49 quad_perm:[1,0,3,2] row_mask:0xf bank_mask:0xf
    v_add_f32_dpp v50, v50, v50 quad_perm:[1,0,3,2] row_mask:0xf bank_mask:0xf
    v_add_f32_dpp v51, v51, v51 quad_perm:[1,0,3,2] row_mask:0xf bank_mask:0xf
    v_add_f32_dpp v44, v44, v44 quad_perm:[2,3,0,1] row_mask:0xf bank_mask:0xf
    v_add_f32_dpp v45, v45, v45 quad_perm:[2,3,0,1] row_mask:0xf bank_mask:0xf
    v_add_f32_dpp v46, v46, v46 quad_perm:[2,3,0,1] row_mask:0xf bank_mask:0xf
    v_add_f32_dpp v47, v47, v47 quad_perm:[2,3,0,1] row_mask:0xf bank_mask:0xf
    v_add_f32_dpp v48, v48, v48 quad_perm:[2,3,0,1] row_mask:0xf bank_mask:0xf
    v_add_f32_dpp v49, v49, v49 quad_perm:[2,3,0,1] row_mask:0xf bank_mask:0xf
    v_add_f32_dpp v50, v50, v50 quad_perm:[2,3,0,1] row_mask:0xf bank_mask:0xf
    v_add_f32_dpp v51, v51, v51 quad_perm:[2,3,0,1] row_mask:0xf bank_mask:0xf
    v_add_f32_dpp v44, v44, v44 row_half_mirror row_mask:0xf bank_mask:0xf
    v_add_f32_dpp v45, v45, v45 row_half_mirror row_mask:0xf bank_mask:0xf
    v_add_f32_dpp v46, v46, v46 row_half_mirror row_mask:0xf bank_mask:0xf
    v_add_f32_dpp v47, v47, v47 row_half_mirror row_mask:0xf bank_mask:0xf
    v_add_f32_dpp v48, v48, v48 row_half_mirror row_mask:0xf bank_mask:0xf
    v_add_f32_dpp v49, v49, v49 row_half_mirror row_mask:0xf bank_mask:0xf
    v_add_f32_dpp v50, v50, v50 row_half_mirror row_mask:0xf bank_mask:0xf
    v_add_f32_dpp v51, v51, v51 row_half_mirror row_mask:0xf bank_mask:0xf
    v_cvt_pk_bf16_f32 v52, v44, v45
    v_cvt_pk_bf16_f32 v53, v46, v47
    v_cvt_pk_bf16_f32 v54, v48, v49
    v_cvt_pk_bf16_f32 v55, v50, v51
    v_lshlrev_b32 v44, 16, v52
    v_and_b32 v45, 0xffff0000, v52
    v_lshlrev_b32 v46, 16, v53
    v_and_b32 v47, 0xffff0000, v53
    v_lshlrev_b32 v48, 16, v54
    v_and_b32 v49, 0xffff0000, v54
    v_lshlrev_b32 v50, 16, v55
    v_and_b32 v51, 0xffff0000, v55
    s_mov_b32 s31, 0xbfb8aa3b
    v_mul_f32 v52, s31, v44
    v_mul_f32 v53, s31, v45
    v_mul_f32 v54, s31, v46
    v_mul_f32 v55, s31, v47
    v_exp_f32 v52, v52
    v_exp_f32 v53, v53
    v_exp_f32 v54, v54
    v_exp_f32 v55, v55
    s_nop 0
    v_add_f32 v52, 1.0, v52
    v_add_f32 v53, 1.0, v53
    v_add_f32 v54, 1.0, v54
    v_add_f32 v55, 1.0, v55
    v_rcp_f32 v56, v52
    v_rcp_f32 v57, v53
    v_rcp_f32 v58, v54
    v_rcp_f32 v59, v55
    s_nop 0
    v_mul_f32 v3, v44, v56
    v_fma_f32 v4, -v3, v52, v44
    v_fma_f32 v44, v4, v56, v3
    v_mul_f32 v3, v45, v57
    v_fma_f32 v4, -v3, v53, v45
    v_fma_f32 v45, v4, v57, v3
    v_mul_f32 v3, v46, v58
    v_fma_f32 v4, -v3, v54, v46
    v_fma_f32 v46, v4, v58, v3
    v_mul_f32 v3, v47, v59
    v_fma_f32 v4, -v3, v55, v47
    v_fma_f32 v47, v4, v59, v3
    v_cvt_pk_bf16_f32 v52, v44, v45
    v_cvt_pk_bf16_f32 v53, v46, v47
    v_lshlrev_b32 v44, 16, v52
    v_and_b32 v45, 0xffff0000, v52
    v_lshlrev_b32 v46, 16, v53
    v_and_b32 v47, 0xffff0000, v53
    v_mul_f32 v44, v44, v48
    v_mul_f32 v45, v45, v49
    v_mul_f32 v46, v46, v50
    v_mul_f32 v47, v47, v51
    v_cvt_pk_bf16_f32 v52, v44, v45
    v_cvt_pk_bf16_f32 v53, v46, v47
    s_mov_b32 exec_lo, 0x01010101
    s_mov_b32 exec_hi, 0x01010101
    ds_write_b64 v120, v[52:53]
    s_mov_b64 exec, -1
    s_waitcnt lgkmcnt(0)
L_x_nohf:
    s_barrier
    s_barrier
    s_cmp_lt_u32 s2, 128
    s_cbranch_scc0 L_fin
    s_mov_b32 s37, 0
    global_load_dwordx4 v[44:47], v122, s[26:27] sc1
L_poll19:
    s_waitcnt vmcnt(0)
    v_perm_b32 v3, v45, v44, s95
    v_perm_b32 v4, v47, v46, s95
    v_perm_b32 v3, v4, v3, s94
    v_xor_b32 v5, v3, v10
    v_cmp_ne_u32 vcc, 0, v5
    s_cbranch_vccz L_poll19_x
    s_add_u32 s37, s37, 1
    s_cmp_gt_u32 s37, 200000
    s_cbranch_scc1 L_poll19_x
    s_mov_b64 exec, vcc
    global_load_dwordx4 v[44:47], v122, s[26:27] sc1
    s_branch L_poll19
L_poll19_x:
    s_mov_b64 exec, -1
    v_and_b32 v44, 0xffffff00, v44
    v_and_b32 v45, 0xffffff00, v45
    v_and_b32 v46, 0xffffff00, v46
    v_and_b32 v47, 0xffffff00, v47
    s_nop 0
    v_add_f32_dpp v44, v44, v44 row_ror:8 row_mask:0xf bank_mask:0xf
    v_add_f32_dpp v45, v45, v45 row_ror:8 row_mask:0xf bank_mask:0xf
    v_add_f32_dpp v46, v46, v46 row_ror:8 row_mask:0xf bank_mask:0xf
    v_add_f32_dpp v47, v47, v47 row_ror:8 row_mask:0xf bank_mask:0xf
    v_add_f32_dpp v44, v44, v44 row_ror:4 row_mask:0xf bank_mask:0xf
    v_add_f32_dpp v45, v45, v45 row_ror:4 row_mask:0xf bank_mask:0xf
    v_add_f32_dpp v46, v46, v46 row_ror:4 row_mask:0xf bank_mask:0xf
    v_add_f32_dpp v47, v47, v47 row_ror:4 row_mask:0xf bank_mask:0xf
    v_add_f32_dpp v44, v44, v44 row_ror:2 row_mask:0xf bank_mask:0xf
    v_add_f32_dpp v45, v45, v45 row_ror:2 row_mask:0xf bank_mask:0xf
    v_add_f32_dpp v46, v46, v46 row_ror:2 row_mask:0xf bank_mask:0xf
    v_add_f32_dpp v47, v47, v47 row_ror:2 row_mask:0xf bank_mask:0xf
    v_add_f32_dpp v44, v44, v44 row_ror:1 row_mask:0xf bank_mask:0xf
    v_add_f32_dpp v45, v45, v45 row_ror:1 row_mask:0xf bank_mask:0xf
    v_add_f32_dpp v46, v46, v46 row_ror:1 row_mask:0xf bank_mask:0xf
    v_add_f32_dpp v47, v47, v47 row_ror:1 row_mask:0xf bank_mask:0xf
    v_add_f32_dpp v44, v44, v44 row_bcast:15 row_mask:0xa bank_mask:0xf
    v_add_f32_dpp v45, v45, v45 row_bcast:15 row_mask:0xa bank_mask:0xf
    v_add_f32_dpp v46, v46, v46 row_bcast:15 row_mask:0xa bank_mask:0xf
    v_add_f32_dpp v47, v47, v47 row_bcast:15 row_mask:0xa bank_mask:0xf
    v_add_f32_dpp v44, v44, v44 row_bcast:31 row_mask:0xc bank_mask:0xf
    v_add_f32_dpp v45, v45, v45 row_bcast:31 row_mask:0xc bank_mask:0xf
    v_add_f32_dpp v46, v46, v46 row_bcast:31 row_mask:0xc bank_mask:0xf
    v_add_f32_dpp v47, v47, v47 row_bcast:31 row_mask:0xc bank_mask:0xf
    v_lshlrev_b32 v48, 16, v124
    v_and_b32 v49, 0xffff0000, v124
    v_lshlrev_b32 v50, 16, v125
    v_and_b32 v51, 0xffff0000, v125
    v_add_f32 v44, v44, v48
    v_add_f32 v45, v45, v49
    v_add_f32 v46, v46, v50
    v_add_f32 v47, v47, v51
    v_cvt_pk_bf16_f32 v52, v44, v45
    v_cvt_pk_bf16_f32 v53, v46, v47
    s_mov_b32 exec_lo, 0
    s_mov_b32 exec_hi, 0x80000000
    global_store_dwordx2 v123, v[52:53], s[22:23]
    s_cmp_eq_u32 s2, 0
    s_cbranch_scc0 L_noep
    global_store_dword v9, v10, s[26:27] offset:0
L_noep:
    s_mov_b64 exec, -1
L_fin:
L_end:
    s_endpgm
.section .rodata,"a"
.p2align 6
.amdhsa_kernel parallel_sum__sliding_block_cached__swiglu_ffn__decode_kernel
  .amdhsa_next_free_vgpr 136
  .amdhsa_next_free_sgpr 102
  .amdhsa_accum_offset 136
  .amdhsa_group_segment_fixed_size 0
  .amdhsa_kernarg_size 96
  .amdhsa_user_sgpr_count 2
  .amdhsa_user_sgpr_kernarg_segment_ptr 1
  .amdhsa_system_sgpr_workgroup_id_x 1
  .amdhsa_float_denorm_mode_32 3
  .amdhsa_float_denorm_mode_16_64 3
.end_amdhsa_kernel
```
